```python
import torch

def _softmax(x, axis=-1):
    return torch.softmax(x, dim=axis)
def _gelu(x):
    return torch.nn.functional.gelu(x, approximate="tanh")
def _silu(x):
    return torch.nn.functional.silu(x)
def _sigmoid(x):
    return torch.sigmoid(x)
def _layernorm(x, axis=-1, eps=1e-5):
    m = x.mean(dim=axis, keepdim=True)
    v = x.var(dim=axis, keepdim=True, unbiased=False)
    return (x - m) / torch.sqrt(v + eps)
def _scatter_add(tgt, idx, src, axis=0):
    return tgt.clone().index_add_(axis, idx, src)
def _segment_sum(src, seg, n):
    out = torch.zeros((n,) + src.shape[1:], dtype=src.dtype)
    return out.index_add_(0, seg, src)
def _pad(x, pw):
    flat = tuple(v for pair in reversed(pw) for v in pair)
    return torch.nn.functional.pad(x, flat)

kernel_name = 'standalone__glu_gated_geglu__sampling'

def setup_inputs():

    _w = (lambda a: (lambda t: t.to(torch.bfloat16) if t.is_floating_point() else t)(torch.as_tensor(a)))
    B, S, Dm, Df = 8, 16, 1024, 3584
    return {
        "x": _w((lambda *s: torch.randn(*s, dtype=torch.bfloat16) * 0.05)(B, S, Dm)),
        "w_gate": _w((lambda *s: torch.randn(*s, dtype=torch.bfloat16) * 0.05)(Dm, Df) * (Dm ** -0.5)),
        "w_up": _w((lambda *s: torch.randn(*s, dtype=torch.bfloat16) * 0.05)(Dm, Df) * (Dm ** -0.5)),
        "w_down": _w((lambda *s: torch.randn(*s, dtype=torch.bfloat16) * 0.05)(Df, Dm) * (Df ** -0.5)),
    }

def reference(x, w_gate, w_up, w_down):
    g = torch.einsum("bsd,df->bsf", x, w_gate)
    u = torch.einsum("bsd,df->bsf", x, w_up)
    h = _gelu(g) * u
    return torch.einsum("bsf,fd->bsd", h, w_down)
```

```asm
; @launch grid=(256,1,1) block=(320,1,1) lds=163840
.amdgcn_target "amdgcn-amd-amdhsa--gfx950"
.text
.globl standalone__glu_gated_geglu__sampling_kernel
.p2align 8
.type standalone__glu_gated_geglu__sampling_kernel,@function
standalone__glu_gated_geglu__sampling_kernel:
  s_load_dwordx8 s[4:11], s[0:1], 0
  s_load_dwordx4 s[44:47], s[0:1], 32
  s_load_dwordx2 s[12:13], s[0:1], 48
  s_cmp_ge_u32 s2, 256
  s_cbranch_scc1 L_end
  v_lshrrev_b32 v1, 6, v0
  v_and_b32 v2, 63, v0
  s_and_b32 s3, s2, 7
  v_readfirstlane_b32 s15, v1
  s_lshr_b32 s14, s2, 3
  v_lshrrev_b32 v3, 3, v2
  v_and_b32 v4, 7, v2
  v_bfe_u32 v5, v2, 4, 1
  s_cmp_lg_u32 s15, 0
  s_cbranch_scc1 L_compute
  s_cmp_ge_u32 s14, 30
  s_cbranch_scc1 L_fill
  s_sub_u32 s48, s14, 14
  s_cmp_ge_u32 s48, 7
  s_cselect_b32 s49, 7, 0
  s_sub_u32 s49, s48, s49
  s_lshl_b32 s49, s49, 6
  v_add_u32 v16, s49, v2
  v_mul_u32_u24 v17, 9363, v16
  v_lshrrev_b32 v17, 16, v17
  v_mul_u32_u24 v18, 7, v17
  v_sub_u32 v18, v16, v18
  v_mul_u32_u24 v17, 7168, v17
  v_lshl_add_u32 v16, v18, 7, v17
  s_mul_i32 s49, s3, 896
  v_add_u32 v16, s49, v16
  s_and_b32 s49, s14, 1
  s_lshl_b32 s49, s49, 6
  v_add_u32 v17, s49, v2
  v_lshlrev_b32 v17, 11, v17
  s_cmp_ge_u32 s14, 28
  s_cselect_b64 vcc, -1, 0
  s_mov_b32 s54, 458752
  s_mov_b32 s22, 7340032
  s_cmov_b32 s54, 128
  s_cmov_b32 s22, 262144
  v_cndmask_b32 v16, v16, v17, vcc
  s_setprio 2
  s_lshr_b32 s49, s14, 1
  s_mul_i32 s50, s3, 7
  s_add_u32 s50, s49, s50
  v_lshlrev_b32 v6, 1, v5
  v_xor_b32 v6, v4, v6
  v_mul_u32_u24 v7, 7168, v3
  s_lshl_b32 s50, s50, 7
  v_add_u32 v7, s50, v7
  v_lshl_add_u32 v8, v6, 4, v7
  v_xor_b32 v6, 4, v6
  v_lshl_add_u32 v10, v6, 4, v7
  v_add_u32 v9, 56320, v8
  v_add_u32 v11, 56320, v10
  v_lshrrev_b32 v6, 1, v3
  v_xor_b32 v6, v4, v6
  s_and_b32 s50, s14, 1
  s_lshl_b32 s50, s50, 6
  v_add_u32 v7, s50, v3
  v_lshlrev_b32 v7, 11, v7
  v_lshl_add_u32 v12, v6, 4, v7
  v_xor_b32 v13, 64, v12
  v_add_u32 v14, 30720, v12
  v_add_u32 v15, 46080, v13
  v_add_u32 v13, 15360, v13
  s_mov_b32 s52, 49152
  s_mov_b32 s56, 0
  s_mov_b32 s57, 0
  s_mov_b32 s23, 0x20000
  s_cmp_lt_u32 s14, 14
  s_waitcnt lgkmcnt(0)
  s_cbranch_scc1 L_p1go
  s_cmp_ge_u32 s14, 21
  s_cselect_b64 s[20:21], s[8:9], s[6:7]
  s_cmp_ge_u32 s14, 28
  s_cselect_b64 s[20:21], s[4:5], s[20:21]

  s_and_b32 s21, s21, 0xffff
  s_lshl_b32 s55, s54, 4
L_pf:
  buffer_load_dword v18, v16, s[20:23], s57 offen
  s_add_u32 s57, s57, s54
  buffer_load_dword v18, v16, s[20:23], s57 offen
  s_add_u32 s57, s57, s54
  s_cmp_lt_u32 s57, s55
  s_cbranch_scc1 L_pf
  s_branch L_pfend
L_p1go:
  s_mov_b32 s20, s6
  s_and_b32 s21, s7, 0xffff
  s_mov_b32 s22, 7340032
  s_mov_b32 s23, 0x20000
  s_sub_u32 s24, s8, 2048
  s_subb_u32 s25, s9, 0
  s_and_b32 s25, s25, 0xffff
  s_mov_b32 s26, 7342080
  s_mov_b32 s27, 0x20000
  s_mov_b32 s16, s4
  s_and_b32 s17, s5, 0xffff
  s_mov_b32 s18, 262144
  s_mov_b32 s19, 0x20000
L_item:
  s_mov_b32 m0, s52
  s_add_u32 s53, s56, 65536
  buffer_load_dwordx4 v8, s[20:23], s57 offen lds
  buffer_load_dwordx4 v9, s[20:23], s57 offen offset:1024 lds
  buffer_load_dwordx4 v10, s[24:27], s57 offen offset:2048 lds
  buffer_load_dwordx4 v11, s[24:27], s57 offen offset:3072 lds
  s_add_u32 m0, m0, 4096
  s_add_u32 s57, s57, 114688
  buffer_load_dwordx4 v8, s[20:23], s57 offen lds
  buffer_load_dwordx4 v9, s[20:23], s57 offen offset:1024 lds
  buffer_load_dwordx4 v10, s[24:27], s57 offen offset:2048 lds
  buffer_load_dwordx4 v11, s[24:27], s57 offen offset:3072 lds
  s_add_u32 m0, m0, 4096
  s_add_u32 s57, s57, 114688
  buffer_load_dwordx4 v8, s[20:23], s57 offen lds
  buffer_load_dwordx4 v9, s[20:23], s57 offen offset:1024 lds
  buffer_load_dwordx4 v10, s[24:27], s57 offen offset:2048 lds
  buffer_load_dwordx4 v11, s[24:27], s57 offen offset:3072 lds
  s_add_u32 m0, m0, 4096
  s_add_u32 s57, s57, 114688
  buffer_load_dwordx4 v8, s[20:23], s57 offen lds
  buffer_load_dwordx4 v9, s[20:23], s57 offen offset:1024 lds
  buffer_load_dwordx4 v10, s[24:27], s57 offen offset:2048 lds
  buffer_load_dwordx4 v11, s[24:27], s57 offen offset:3072 lds
  s_add_u32 m0, m0, 4096
  s_add_u32 s57, s57, 114688
  buffer_load_dwordx4 v12, s[16:19], s56 offen lds
  buffer_load_dwordx4 v13, s[16:19], s56 offen offset:1024 lds
  buffer_load_dwordx4 v14, s[16:19], s56 offen offset:2048 lds
  buffer_load_dwordx4 v15, s[16:19], s56 offen offset:3072 lds
  s_add_u32 m0, m0, 4096
  s_add_u32 s52, s52, 24576
  buffer_load_dwordx4 v12, s[16:19], s53 offen lds
  buffer_load_dwordx4 v13, s[16:19], s53 offen offset:1024 lds
  buffer_load_dwordx4 v14, s[16:19], s53 offen offset:2048 lds
  buffer_load_dwordx4 v15, s[16:19], s53 offen offset:3072 lds
  s_cmp_eq_u32 s52, 98304
  s_cmov_b32 s52, 0
  s_add_u32 s56, s56, 128
  s_cmp_lt_u32 s56, 384
  s_cbranch_scc1 L_item
  s_cmp_lt_u32 s56, 2048
  s_waitcnt vmcnt(48)
  s_barrier
  s_cbranch_scc1 L_item
  v_lshlrev_b32 v6, 2, v5
  v_xor_b32 v6, v4, v6
  v_lshlrev_b32 v7, 11, v3
  s_and_b32 s49, s3, 1
  s_lshl_b32 s49, s49, 10
  s_lshr_b32 s51, s14, 2
  s_lshl_b32 s51, s51, 7
  v_add_u32 v7, s51, v7
  v_lshl_add_u32 v20, v6, 4, v7
  v_add_u32 v21, 15360, v20
  v_add_u32 v22, 30720, v20
  v_add_u32 v23, 46080, v20
  s_lshr_b32 s58, s3, 1
  s_mul_i32 s58, s58, 1835008
  s_add_u32 s58, s58, s49
  v_and_b32 v24, 15, v2
  v_lshlrev_b32 v24, 7, v24
  v_add_u32 v24, 983040, v24
  v_mov_b32 v25, 0
  s_lshl_b32 s50, s2, 8
  s_add_u32 s50, s50, 917504
  s_add_u32 s36, s12, s50
  s_addc_u32 s37, s13, 0
  s_mov_b32 s28, s10
  s_and_b32 s29, s11, 0xffff
  s_mov_b32 s30, 7340032
  s_mov_b32 s31, 0x20000
  s_mov_b32 s32, s12
  s_and_b32 s33, s13, 0xffff
  s_mov_b32 s34, 268435456
  s_mov_b32 s35, 0x20000
  s_movk_i32 s62, 4096
  s_mov_b32 s63, 65536
  s_mov_b32 m0, 98304
  s_add_u32 s60, s58, 786432
  s_add_u32 s61, s60, 262144
L_wd0:
  buffer_load_dwordx4 v20, s[28:31], s60 offen offset:0 lds
  buffer_load_dwordx4 v21, s[28:31], s60 offen offset:1024 lds
  buffer_load_dwordx4 v22, s[28:31], s60 offen offset:2048 lds
  buffer_load_dwordx4 v23, s[28:31], s60 offen offset:3072 lds
  s_add_u32 m0, m0, 4096
  s_add_u32 s60, s60, 65536
  s_cmp_lt_u32 s60, s61
  s_cbranch_scc1 L_wd0
  s_waitcnt vmcnt(40)
  s_barrier
  s_add_u32 s61, s60, 393216
L_wd1:
  buffer_load_dwordx4 v20, s[28:31], s60 offen offset:0 lds
  buffer_load_dwordx4 v21, s[28:31], s60 offen offset:1024 lds
  buffer_load_dwordx4 v22, s[28:31], s60 offen offset:2048 lds
  buffer_load_dwordx4 v23, s[28:31], s60 offen offset:3072 lds
  s_add_u32 m0, m0, 4096
  s_add_u32 s60, s60, 65536
  s_cmp_lt_u32 s60, s61
  s_cbranch_scc1 L_wd1
  s_waitcnt vmcnt(40)
  s_barrier
  s_add_u32 s61, s60, 393216
L_wd2:
  buffer_load_dwordx4 v20, s[28:31], s60 offen offset:0 lds
  buffer_load_dwordx4 v21, s[28:31], s60 offen offset:1024 lds
  buffer_load_dwordx4 v22, s[28:31], s60 offen offset:2048 lds
  buffer_load_dwordx4 v23, s[28:31], s60 offen offset:3072 lds
  s_add_u32 m0, m0, 4096
  s_add_u32 s60, s60, 65536
  s_cmp_lt_u32 s60, s61
  s_cbranch_scc1 L_wd2
  s_mov_b32 m0, 49152
  s_mov_b32 s60, s58
  s_add_u32 s61, s60, 65536
L_wd3:
  buffer_load_dwordx4 v20, s[28:31], s60 offen offset:0 lds
  buffer_load_dwordx4 v21, s[28:31], s60 offen offset:1024 lds
  buffer_load_dwordx4 v22, s[28:31], s60 offen offset:2048 lds
  buffer_load_dwordx4 v23, s[28:31], s60 offen offset:3072 lds
  s_add_u32 m0, m0, 4096
  s_add_u32 s60, s60, 65536
  s_cmp_lt_u32 s60, s61
  s_cbranch_scc1 L_wd3
  s_barrier
  s_barrier
  s_add_u32 s61, s60, 720896
L_wd4:
  buffer_load_dwordx4 v20, s[28:31], s60 offen offset:0 lds
  buffer_load_dwordx4 v21, s[28:31], s60 offen offset:1024 lds
  buffer_load_dwordx4 v22, s[28:31], s60 offen offset:2048 lds
  buffer_load_dwordx4 v23, s[28:31], s60 offen offset:3072 lds
  s_add_u32 m0, m0, 4096
  s_add_u32 s60, s60, 65536
  s_cmp_lt_u32 s60, s61
  s_cbranch_scc1 L_wd4
L_agent:
  s_barrier
  s_waitcnt vmcnt(0)
  s_barrier
  s_barrier
  s_mov_b32 s59, 0
L_hb:
  s_load_dwordx4 s[84:87], s[36:37], 64 glc
  s_add_u32 s59, s59, 1
  s_cmp_ge_u32 s59, 65536
  s_waitcnt lgkmcnt(0)
  s_cbranch_scc1 L_hokb
  s_max_u32 s84, s84, s85
  s_max_u32 s84, s84, s86
  s_max_u32 s84, s84, s87
  s_cmp_eq_u32 s84, -1
  s_cbranch_scc1 L_hb
L_hokb:
  s_barrier
L_end:
  s_endpgm
L_pfend:
  v_lshlrev_b32 v6, 2, v5
  v_xor_b32 v6, v4, v6
  v_lshlrev_b32 v7, 11, v3
  s_and_b32 s49, s3, 1
  s_lshl_b32 s49, s49, 10
  s_lshr_b32 s51, s14, 2
  s_lshl_b32 s51, s51, 7
  v_add_u32 v7, s51, v7
  v_lshl_add_u32 v20, v6, 4, v7
  v_add_u32 v21, 15360, v20
  v_add_u32 v22, 30720, v20
  v_add_u32 v23, 46080, v20
  s_lshr_b32 s58, s3, 1
  s_mul_i32 s58, s58, 1835008
  s_add_u32 s58, s58, s49
  v_and_b32 v24, 15, v2
  v_lshlrev_b32 v24, 7, v24
  v_add_u32 v24, 983040, v24
  v_mov_b32 v25, 0
  s_lshl_b32 s50, s2, 8
  s_add_u32 s50, s50, 917504
  s_add_u32 s36, s12, s50
  s_addc_u32 s37, s13, 0
  s_mov_b32 s28, s10
  s_and_b32 s29, s11, 0xffff
  s_mov_b32 s30, 7340032
  s_mov_b32 s31, 0x20000
  s_mov_b32 s32, s12
  s_and_b32 s33, s13, 0xffff
  s_mov_b32 s34, 268435456
  s_mov_b32 s35, 0x20000
  s_movk_i32 s62, 4096
  s_mov_b32 s63, 65536
  s_mov_b32 s40, s46
  s_and_b32 s41, s47, 0xffff
  s_mov_b32 s42, 256
  s_mov_b32 s43, 0x20000
  buffer_load_dword v27, v25, s[40:43], 0 offen sc1
  buffer_load_dword v26, v24, s[32:35], 0 offen sc1
  s_mul_i32 s52, s48, 36
  s_add_u32 s50, s52, 36
  s_lshr_b32 s52, s52, 4
  s_lshr_b32 s50, s50, 4
  s_add_u32 s52, s52, 20
  s_add_u32 s50, s50, 20
L_pfw:
  v_lshrrev_b32 v6, 2, v2
  v_and_b32 v7, 3, v2
  v_lshl_add_u32 v6, v6, 4, v7
  v_lshlrev_b32 v6, 7, v6
  s_lshl_b32 s52, s52, 15
  s_lshl_b32 s50, s50, 15
  s_add_u32 s52, s52, s58
  s_add_u32 s50, s50, s58
L_pfw1:
  buffer_load_dword v30, v6, s[28:31], s52 offen
  s_add_u32 s52, s52, 32768
  s_cmp_lt_u32 s52, s50
  s_cbranch_scc1 L_pfw1
  s_and_b32 s52, s14, 3
  s_mov_b32 s53, 0
L_wdq:
  s_mul_i32 s60, s52, 28672
  s_add_u32 m0, s60, 49152
  s_lshl_b32 s60, s60, 4
  s_add_u32 s60, s60, s58
  s_add_u32 s61, s60, 458752
L_wd5:
  buffer_load_dwordx4 v20, s[28:31], s60 offen offset:0 lds
  buffer_load_dwordx4 v21, s[28:31], s60 offen offset:1024 lds
  buffer_load_dwordx4 v22, s[28:31], s60 offen offset:2048 lds
  buffer_load_dwordx4 v23, s[28:31], s60 offen offset:3072 lds
  s_add_u32 m0, m0, 4096
  s_add_u32 s60, s60, 65536
  s_cmp_lt_u32 s60, s61
  s_cbranch_scc1 L_wd5
  s_add_u32 s52, s52, 1
  s_and_b32 s52, s52, 3
  s_add_u32 s53, s53, 1
  s_cmp_lt_u32 s53, 4
  s_cbranch_scc1 L_wdq
  buffer_load_dword v27, v25, s[40:43], 0 offen sc1
  buffer_load_dword v26, v24, s[32:35], 0 offen sc1
  s_waitcnt vmcnt(0)
  s_mov_b32 s59, 0
L_fb:
  v_cmp_ne_u32 vcc, v26, v27
  v_cmp_eq_u32 s[26:27], 0, v27
  s_or_b64 vcc, vcc, s[26:27]
  s_cbranch_vccz L_fokb
  s_add_u32 s59, s59, 1
  s_cmp_ge_u32 s59, 65536
  s_cbranch_scc1 L_fokb
  s_sleep 8
  buffer_load_dword v27, v25, s[40:43], 0 offen sc1
  buffer_load_dword v26, v24, s[32:35], 0 offen sc1
  s_waitcnt vmcnt(0)
  s_branch L_fb
L_fokb:
  s_barrier
  s_branch L_agent
L_fill:
  s_memrealtime s[62:63]
  v_lshlrev_b32 v12, 4, v2
  v_mov_b32 v8, -1
  v_mov_b32 v9, -1
  v_mov_b32 v10, -1
  v_mov_b32 v11, -1
  s_sub_u32 s54, s2, 240
  s_mul_i32 s55, s54, 61440
  s_add_u32 s56, s55, 61440
  s_lshl_b32 s54, s54, 7
  s_add_u32 s54, s54, 983040
  v_mov_b32 v17, 0
  s_waitcnt lgkmcnt(0)
  s_mov_b32 s32, s12
  s_and_b32 s33, s13, 0xffff
  s_mov_b32 s34, 268435456
  s_mov_b32 s35, 0x20000
  s_mov_b32 s40, s46
  s_and_b32 s41, s47, 0xffff
  s_mov_b32 s42, 256
  s_mov_b32 s43, 0x20000
  s_cmp_lg_u32 s2, 240
  s_cbranch_scc1 L_clr0
  s_mul_i32 s62, s62, 0x9e3779b1
  s_and_b32 s62, s62, 0xfefefefe
  s_or_b32 s62, s62, 0x00010001
  v_mov_b32 v16, s62
  s_mov_b64 exec, 1
  buffer_store_dword v16, v17, s[40:43], 0 offen sc1
  s_mov_b64 exec, -1
L_clr0:
  buffer_store_dwordx4 v[8:11], v12, s[32:35], s55 offen offset:0 sc1
  buffer_store_dwordx4 v[8:11], v12, s[32:35], s55 offen offset:1024 sc1
  buffer_store_dwordx4 v[8:11], v12, s[32:35], s55 offen offset:2048 sc1
  buffer_store_dwordx4 v[8:11], v12, s[32:35], s55 offen offset:3072 sc1
  s_add_u32 s55, s55, 4096
  s_cmp_lt_u32 s55, s56
  s_cbranch_scc1 L_clr0
  s_mov_b32 s59, 0
L_getn:
  buffer_load_dword v16, v17, s[40:43], 0 offen sc1
  s_add_u32 s59, s59, 1
  s_cmp_ge_u32 s59, 65536
  s_waitcnt vmcnt(0)
  v_cmp_eq_u32 vcc, 0, v16
  s_cbranch_scc1 L_gotn
  s_cbranch_vccnz L_getn
L_gotn:
  v_mov_b32 v17, v16
  v_mov_b32 v18, v16
  v_mov_b32 v19, v16
  s_mov_b64 exec, 0xff
  buffer_store_dwordx4 v[16:19], v12, s[32:35], s54 offen sc1
  s_mov_b64 exec, -1
  v_lshlrev_b32 v6, 2, v5
  v_xor_b32 v6, v4, v6
  v_lshlrev_b32 v7, 11, v3
  s_and_b32 s49, s3, 1
  s_lshl_b32 s49, s49, 10
  s_lshr_b32 s51, s14, 2
  s_lshl_b32 s51, s51, 7
  v_add_u32 v7, s51, v7
  v_lshl_add_u32 v20, v6, 4, v7
  v_add_u32 v21, 15360, v20
  v_add_u32 v22, 30720, v20
  v_add_u32 v23, 46080, v20
  s_lshr_b32 s58, s3, 1
  s_mul_i32 s58, s58, 1835008
  s_add_u32 s58, s58, s49
  v_and_b32 v24, 15, v2
  v_lshlrev_b32 v24, 7, v24
  v_add_u32 v24, 983040, v24
  v_mov_b32 v25, 0
  s_lshl_b32 s50, s2, 8
  s_add_u32 s50, s50, 917504
  s_add_u32 s36, s12, s50
  s_addc_u32 s37, s13, 0
  s_mov_b32 s28, s10
  s_and_b32 s29, s11, 0xffff
  s_mov_b32 s30, 7340032
  s_mov_b32 s31, 0x20000
  s_mov_b32 s32, s12
  s_and_b32 s33, s13, 0xffff
  s_mov_b32 s34, 268435456
  s_mov_b32 s35, 0x20000
  s_movk_i32 s62, 4096
  s_mov_b32 s63, 65536
  s_sub_u32 s48, s14, 30
  s_mul_i32 s52, s48, 10
  s_add_u32 s50, s52, 10
  s_branch L_pfw
L_aend:
.p2align 12
L_page:
L_compute:
  s_sub_u32 s15, s15, 1
  v_subrev_u32 v0, 64, v0
  v_lshlrev_b32 v5, 4, v2
  v_and_b32 v146, 15, v2
  v_lshlrev_b32 v146, 7, v146
  v_add_u32 v146, 983040, v146
  s_and_b32 s62, s15, 3
  s_and_b32 s48, s3, 1
  s_lshr_b32 s49, s3, 1
  s_and_b32 s63, s14, 3
  v_bfe_u32 v16, v2, 4, 1
  v_lshrrev_b32 v17, 5, v2
  v_bfe_u32 v18, v2, 2, 2
  v_and_b32 v19, 3, v2
  v_bfe_u32 v10, v2, 1, 3
  v_and_b32 v11, 1, v2
  v_lshl_add_u32 v165, v10, 2, v11
  v_lshl_add_u32 v165, v165, 3, v16
  s_and_b32 s50, s14, 1
  s_lshl_b32 s50, s50, 4
  s_and_b32 s51, s3, 6
  s_add_u32 s50, s50, s51
  s_lshl_b32 s50, s50, 1
  s_add_u32 s50, s50, s48
  s_lshl_b32 s50, s50, 5
  s_lshr_b32 s51, s14, 1
  s_add_u32 s50, s50, s51
  s_lshl_b32 s50, s50, 2
  s_add_u32 s50, s50, 917504
  v_lshl_add_u32 v165, v165, 8, s50
  s_lshl_b32 s50, s14, 3
  s_add_u32 s50, s50, s48
  s_lshl_b32 s50, s50, 6
  s_add_u32 s50, s50, s49
  s_lshl_b32 s50, s50, 2
  s_add_u32 s50, s50, 917568
  v_lshl_add_u32 v167, v0, 9, s50
  v_mov_b32 v166, 268435456
  v_subrev_u32 v13, 192, v0
  v_cmp_gt_u32 vcc, 32, v13
  v_lshrrev_b32 v12, 1, v18
  s_lshr_b32 s50, s62, 1
  v_cndmask_b32 v165, v166, v165, vcc
  v_cmp_gt_u32 vcc, 4, v0
  v_lshl_add_u32 v11, v17, 2, v18
  v_xor_b32 v13, s50, v12
  v_cndmask_b32 v167, v166, v167, vcc
  v_mov_b32 v166, 0
  v_lshl_add_u32 v11, v11, 1, v13
  s_and_b32 s50, s62, 1
  v_xor_b32 v13, s50, v16
  v_lshl_add_u32 v11, v11, 1, v13
  v_lshl_add_u32 v11, v11, 2, v19
  v_lshlrev_b32 v11, 3, v11
  s_mul_i32 s51, s62, 28672
  s_add_u32 s51, s51, 49152
  v_xor_b32 v161, 64, v11
  v_add_u32 v160, s51, v11
  v_add_u32 v161, s51, v161
  s_lshl_b32 s52, s63, 2
  s_add_u32 s52, s52, s49
  s_lshl_b32 s52, s52, 2
  s_add_u32 s52, s52, s62
  s_mul_i32 s54, s52, 14336
  s_add_u32 s55, s54, 4096
  s_add_u32 s56, s54, 8192
  s_add_u32 s57, s54, 12288
  s_lshl_b32 s51, s63, 2
  s_add_u32 s51, s51, s49
  s_lshl_b32 s51, s51, 4
  s_add_u32 s51, s51, s48
  s_lshl_b32 s51, s51, 3
  s_lshr_b32 s50, s14, 2
  s_add_u32 s51, s51, s50
  s_lshl_b32 s58, s51, 7
  s_lshl_b32 s50, s48, 5
  s_add_u32 s50, s50, s14
  s_lshl_b32 s50, s50, 4
  s_add_u32 s50, s50, s49
  s_lshl_b32 s50, s50, 11
  s_add_u32 s50, s50, 1048576
  s_lshl_b32 s51, s62, 9
  s_add_u32 s52, s50, s51
  v_lshl_add_u32 v163, v2, 3, s51
  s_lshl_b32 s51, s49, 13
  s_add_u32 s50, s50, s51
  s_xor_b32 s16, s50, 0x800
  s_xor_b32 s17, s50, 0x1000
  s_xor_b32 s18, s50, 0x1800
  v_lshl_add_u32 v13, v17, 1, v16
  v_and_b32 v162, 1, v2
  v_lshl_add_u32 v13, v13, 1, v162
  s_lshl_b32 s50, s62, 3
  v_add_u32 v13, s50, v13
  v_lshlrev_b32 v162, 7, v10
  v_lshl_add_u32 v162, v13, 2, v162
  v_lshl_add_u32 v148, v17, 3, v4
  v_lshlrev_b32 v148, 4, v148
  v_and_b32 v13, 3, v3
  v_cmp_eq_u32 s[28:29], s49, v13
  v_lshl_add_u32 v13, v13, 13, v148
  v_mov_b32 v11, 268435456
  s_lshl_b32 s50, s62, 9
  v_add_u32 v149, s50, v148
  v_cndmask_b32 v148, v13, v11, s[28:29]
  v_lshlrev_b32 v150, 11, v3
  v_lshl_add_u32 v150, v4, 4, v150
  s_lshl_b32 s50, s62, 13
  v_add_u32 v3, s50, v5
  s_waitcnt lgkmcnt(0)
  s_mov_b32 s32, s12
  s_and_b32 s33, s13, 0xffff
  s_mov_b32 s34, 268435456
  s_mov_b32 s35, 0x20000
  s_mov_b32 s40, s46
  s_and_b32 s41, s47, 0xffff
  s_mov_b32 s42, 256
  s_mov_b32 s43, 0x20000
  s_mov_b32 s36, s44
  s_and_b32 s37, s45, 0xffff
  s_mov_b32 s38, 262144
  s_mov_b32 s39, 0x20000
  s_lshl_b32 s50, s2, 1
  s_lshr_b32 s51, s62, 1
  s_add_u32 s50, s50, s51
  s_lshl_b32 s50, s50, 7
  s_bitcmp1_b32 s62, 0
  s_cselect_b32 s51, 12, 0
  s_add_u32 s51, s51, 917504
  s_add_u32 s50, s50, s51
  s_add_u32 s20, s12, s50
  s_addc_u32 s21, s13, 0
  s_cmp_ge_u32 s14, 14
  s_cbranch_scc1 L_p2f
L_cgo:

  s_movk_i32 s50, 16384
  v_lshl_add_u32 v11, v17, 3, v18
  v_lshl_add_u32 v11, v16, 4, v11
  v_lshl_or_b32 v13, v16, 1, v12
  v_xor_b32 v13, s62, v13
  v_lshl_add_u32 v11, v11, 2, v13
  v_lshl_add_u32 v11, v11, 2, v19
  v_lshlrev_b32 v6, 3, v11
  v_add_u32 v7, 73728, v6
  v_xor_b32 v11, v17, v10
  v_and_b32 v10, 31, v2
  v_lshl_add_u32 v11, v10, 3, v11
  v_lshl_add_u32 v8, v11, 4, s50
  v_xor_b32 v9, 32, v8
  v_xor_b32 v10, 64, v8
  v_xor_b32 v11, 96, v8
  v_add_u32 v12, 73728, v8
  v_add_u32 v13, 73728, v9
  v_add_u32 v14, 73728, v10
  v_add_u32 v15, 73728, v11
  s_and_b32 s60, s14, 1
  s_lshl_b32 s60, s60, 4
  s_add_u32 s60, s60, s3
  s_mul_i32 s60, s60, 7
  s_lshr_b32 s50, s14, 1
  s_add_u32 s60, s60, s50
  s_lshl_b32 s60, s60, 2
  s_add_u32 s60, s60, s62
  s_lshl_b32 s60, s60, 10
  s_add_u32 s61, s60, 229376
  s_mov_b32 s50, 0xbdd2d3e8
  s_mov_b32 s51, s50
  v_mov_b32 v100, 0xc0135761
  v_mov_b32 v101, 0xc0135761
  s_cmp_eq_u32 s15, 0
  s_cselect_b32 s25, 16, 0
  s_mov_b32 s23, 0
  v_mov_b64 v[112:113], 0
  v_mov_b64 v[114:115], 0
  v_mov_b64 v[116:117], 0
  v_mov_b64 v[118:119], 0
  v_mov_b64 v[120:121], 0
  v_mov_b64 v[122:123], 0
  v_mov_b64 v[124:125], 0
  v_mov_b64 v[126:127], 0
  v_mov_b64 v[128:129], 0
  v_mov_b64 v[130:131], 0
  v_mov_b64 v[132:133], 0
  v_mov_b64 v[134:135], 0
  v_mov_b64 v[136:137], 0
  v_mov_b64 v[138:139], 0
  v_mov_b64 v[140:141], 0
  v_mov_b64 v[142:143], 0
  v_mov_b64 v[64:65], 0
  v_mov_b64 v[66:67], 0
  v_mov_b64 v[68:69], 0
  v_mov_b64 v[70:71], 0
  v_mov_b64 v[72:73], 0
  v_mov_b64 v[74:75], 0
  s_branch L_main
L_fl0:
  buffer_load_dword v145, v166, s[40:43], 0 offen sc1
  buffer_load_dword v144, v146, s[32:35], 0 offen sc1
  s_branch L_flb0
L_fl2:
  s_waitcnt vmcnt(0)
  v_cmp_ne_u32 vcc, v144, v145
  v_cmp_eq_u32 s[26:27], 0, v145
  s_or_b64 vcc, vcc, s[26:27]
  s_cbranch_vccz L_flb2
  s_branch L_fslow
L_main:
  s_add_u32 s23, s23, 4
  s_barrier
  ds_read_b64_tr_b16 v[16:17], v6 offset:49152
  ds_read_b64_tr_b16 v[18:19], v6 offset:49664
  ds_read_b128 v[20:23], v8 offset:49152
  ds_read_b128 v[24:27], v8 offset:53248
  ds_read_b64_tr_b16 v[28:29], v6 offset:53248
  ds_read_b64_tr_b16 v[30:31], v6 offset:53760
  ds_read_b128 v[32:35], v9 offset:49152
  ds_read_b128 v[36:39], v9 offset:53248
  v_mfma_f32_32x32x16_bf16 v[112:127], v[64:67], v[68:71], v[112:127]
  ds_read_b64_tr_b16 v[40:41], v6 offset:57344
  ds_read_b64_tr_b16 v[42:43], v6 offset:57856
  ds_read_b128 v[44:47], v10 offset:49152
  ds_read_b128 v[48:51], v10 offset:53248
  v_mfma_f32_32x32x16_bf16 v[128:143], v[64:67], v[72:75], v[128:143]
  ds_read_b64_tr_b16 v[52:53], v6 offset:61440
  ds_read_b64_tr_b16 v[54:55], v6 offset:61952
  ds_read_b128 v[56:59], v11 offset:49152
  ds_read_b128 v[60:63], v11 offset:53248
  s_waitcnt lgkmcnt(13)
  v_mfma_f32_32x32x16_bf16 v[112:127], v[16:19], v[20:23], v[112:127]
  s_waitcnt lgkmcnt(12)
  v_mfma_f32_32x32x16_bf16 v[128:143], v[16:19], v[24:27], v[128:143]
  s_waitcnt lgkmcnt(9)
  v_mfma_f32_32x32x16_bf16 v[112:127], v[28:31], v[32:35], v[112:127]
  s_waitcnt lgkmcnt(8)
  v_mfma_f32_32x32x16_bf16 v[128:143], v[28:31], v[36:39], v[128:143]
  s_waitcnt lgkmcnt(5)
  v_mfma_f32_32x32x16_bf16 v[112:127], v[40:43], v[44:47], v[112:127]
  s_waitcnt lgkmcnt(4)
  v_mfma_f32_32x32x16_bf16 v[128:143], v[40:43], v[48:51], v[128:143]
  s_waitcnt lgkmcnt(0)
  s_cmp_eq_u32 s23, s25
  s_cbranch_scc1 L_fl0
L_flb0:
  s_barrier
  ds_read_b64_tr_b16 v[16:17], v7 offset:0
  ds_read_b64_tr_b16 v[18:19], v7 offset:512
  ds_read_b128 v[20:23], v12 offset:0
  ds_read_b128 v[24:27], v12 offset:4096
  ds_read_b64_tr_b16 v[28:29], v7 offset:4096
  ds_read_b64_tr_b16 v[30:31], v7 offset:4608
  ds_read_b128 v[32:35], v13 offset:0
  ds_read_b128 v[36:39], v13 offset:4096
  v_mfma_f32_32x32x16_bf16 v[112:127], v[52:55], v[56:59], v[112:127]
  ds_read_b64_tr_b16 v[40:41], v7 offset:8192
  ds_read_b64_tr_b16 v[42:43], v7 offset:8704
  ds_read_b128 v[44:47], v14 offset:0
  ds_read_b128 v[48:51], v14 offset:4096
  v_mfma_f32_32x32x16_bf16 v[128:143], v[52:55], v[60:63], v[128:143]
  ds_read_b64_tr_b16 v[64:65], v7 offset:12288
  ds_read_b64_tr_b16 v[66:67], v7 offset:12800
  ds_read_b128 v[68:71], v15 offset:0
  ds_read_b128 v[72:75], v15 offset:4096
  s_waitcnt lgkmcnt(13)
  v_mfma_f32_32x32x16_bf16 v[112:127], v[16:19], v[20:23], v[112:127]
  s_waitcnt lgkmcnt(12)
  v_mfma_f32_32x32x16_bf16 v[128:143], v[16:19], v[24:27], v[128:143]
  s_waitcnt lgkmcnt(9)
  v_mfma_f32_32x32x16_bf16 v[112:127], v[28:31], v[32:35], v[112:127]
  s_waitcnt lgkmcnt(8)
  v_mfma_f32_32x32x16_bf16 v[128:143], v[28:31], v[36:39], v[128:143]
  s_waitcnt lgkmcnt(5)
  v_mfma_f32_32x32x16_bf16 v[112:127], v[40:43], v[44:47], v[112:127]
  s_waitcnt lgkmcnt(4)
  v_mfma_f32_32x32x16_bf16 v[128:143], v[40:43], v[48:51], v[128:143]
  s_waitcnt lgkmcnt(0)
  s_barrier
  ds_read_b64_tr_b16 v[16:17], v6 offset:0
  ds_read_b64_tr_b16 v[18:19], v6 offset:512
  ds_read_b128 v[20:23], v8 offset:0
  ds_read_b128 v[24:27], v8 offset:4096
  ds_read_b64_tr_b16 v[28:29], v6 offset:4096
  ds_read_b64_tr_b16 v[30:31], v6 offset:4608
  ds_read_b128 v[32:35], v9 offset:0
  ds_read_b128 v[36:39], v9 offset:4096
  v_mfma_f32_32x32x16_bf16 v[112:127], v[64:67], v[68:71], v[112:127]
  ds_read_b64_tr_b16 v[40:41], v6 offset:8192
  ds_read_b64_tr_b16 v[42:43], v6 offset:8704
  ds_read_b128 v[44:47], v10 offset:0
  ds_read_b128 v[48:51], v10 offset:4096
  v_mfma_f32_32x32x16_bf16 v[128:143], v[64:67], v[72:75], v[128:143]
  ds_read_b64_tr_b16 v[52:53], v6 offset:12288
  ds_read_b64_tr_b16 v[54:55], v6 offset:12800
  ds_read_b128 v[56:59], v11 offset:0
  ds_read_b128 v[60:63], v11 offset:4096
  s_waitcnt lgkmcnt(13)
  v_mfma_f32_32x32x16_bf16 v[112:127], v[16:19], v[20:23], v[112:127]
  s_waitcnt lgkmcnt(12)
  v_mfma_f32_32x32x16_bf16 v[128:143], v[16:19], v[24:27], v[128:143]
  s_waitcnt lgkmcnt(9)
  v_mfma_f32_32x32x16_bf16 v[112:127], v[28:31], v[32:35], v[112:127]
  s_waitcnt lgkmcnt(8)
  v_mfma_f32_32x32x16_bf16 v[128:143], v[28:31], v[36:39], v[128:143]
  s_waitcnt lgkmcnt(5)
  v_mfma_f32_32x32x16_bf16 v[112:127], v[40:43], v[44:47], v[112:127]
  s_waitcnt lgkmcnt(4)
  v_mfma_f32_32x32x16_bf16 v[128:143], v[40:43], v[48:51], v[128:143]
  s_waitcnt lgkmcnt(0)
  s_cmp_eq_u32 s23, s25
  s_cbranch_scc1 L_fl2
L_flb2:
  s_barrier
  ds_read_b64_tr_b16 v[16:17], v6 offset:24576
  ds_read_b64_tr_b16 v[18:19], v6 offset:25088
  ds_read_b128 v[20:23], v8 offset:24576
  ds_read_b128 v[24:27], v8 offset:28672
  ds_read_b64_tr_b16 v[28:29], v6 offset:28672
  ds_read_b64_tr_b16 v[30:31], v6 offset:29184
  ds_read_b128 v[32:35], v9 offset:24576
  ds_read_b128 v[36:39], v9 offset:28672
  v_mfma_f32_32x32x16_bf16 v[112:127], v[52:55], v[56:59], v[112:127]
  ds_read_b64_tr_b16 v[40:41], v6 offset:32768
  ds_read_b64_tr_b16 v[42:43], v6 offset:33280
  ds_read_b128 v[44:47], v10 offset:24576
  ds_read_b128 v[48:51], v10 offset:28672
  v_mfma_f32_32x32x16_bf16 v[128:143], v[52:55], v[60:63], v[128:143]
  ds_read_b64_tr_b16 v[64:65], v6 offset:36864
  ds_read_b64_tr_b16 v[66:67], v6 offset:37376
  ds_read_b128 v[68:71], v11 offset:24576
  ds_read_b128 v[72:75], v11 offset:28672
  s_waitcnt lgkmcnt(13)
  v_mfma_f32_32x32x16_bf16 v[112:127], v[16:19], v[20:23], v[112:127]
  s_waitcnt lgkmcnt(12)
  v_mfma_f32_32x32x16_bf16 v[128:143], v[16:19], v[24:27], v[128:143]
  s_waitcnt lgkmcnt(9)
  v_mfma_f32_32x32x16_bf16 v[112:127], v[28:31], v[32:35], v[112:127]
  s_waitcnt lgkmcnt(8)
  v_mfma_f32_32x32x16_bf16 v[128:143], v[28:31], v[36:39], v[128:143]
  s_waitcnt lgkmcnt(5)
  v_mfma_f32_32x32x16_bf16 v[112:127], v[40:43], v[44:47], v[112:127]
  s_waitcnt lgkmcnt(4)
  v_mfma_f32_32x32x16_bf16 v[128:143], v[40:43], v[48:51], v[128:143]
  s_waitcnt lgkmcnt(0)
  s_cmp_lt_u32 s23, 16
  s_cbranch_scc1 L_main
L_tail1:
  v_mfma_f32_32x32x16_bf16 v[112:127], v[64:67], v[68:71], v[112:127]
  v_mfma_f32_32x32x16_bf16 v[128:143], v[64:67], v[72:75], v[128:143]
  s_nop 10
  v_cvt_pk_bf16_f32 v16, 0, v112
  v_cvt_pk_bf16_f32 v17, 0, v113
  v_cvt_pk_bf16_f32 v18, 0, v114
  v_cvt_pk_bf16_f32 v19, 0, v115
  v_cvt_pk_bf16_f32 v20, 0, v116
  v_cvt_pk_bf16_f32 v21, 0, v117
  v_cvt_pk_bf16_f32 v22, 0, v118
  v_cvt_pk_bf16_f32 v23, 0, v119
  v_cvt_pk_bf16_f32 v24, 0, v120
  v_cvt_pk_bf16_f32 v25, 0, v121
  v_cvt_pk_bf16_f32 v26, 0, v122
  v_cvt_pk_bf16_f32 v27, 0, v123
  v_cvt_pk_bf16_f32 v28, 0, v124
  v_cvt_pk_bf16_f32 v29, 0, v125
  v_cvt_pk_bf16_f32 v30, 0, v126
  v_cvt_pk_bf16_f32 v31, 0, v127
  v_pk_mul_f32 v[32:33], v[16:17], v[16:17]
  v_pk_mul_f32 v[34:35], v[18:19], v[18:19]
  v_pk_mul_f32 v[36:37], v[20:21], v[20:21]
  v_pk_mul_f32 v[38:39], v[22:23], v[22:23]
  v_pk_fma_f32 v[32:33], v[32:33], s[50:51], v[100:101]
  v_pk_fma_f32 v[34:35], v[34:35], s[50:51], v[100:101]
  v_pk_fma_f32 v[36:37], v[36:37], s[50:51], v[100:101]
  v_pk_fma_f32 v[38:39], v[38:39], s[50:51], v[100:101]
  v_pk_mul_f32 v[32:33], v[32:33], v[16:17]
  v_pk_mul_f32 v[34:35], v[34:35], v[18:19]
  v_pk_mul_f32 v[36:37], v[36:37], v[20:21]
  v_pk_mul_f32 v[38:39], v[38:39], v[22:23]
  v_exp_f32 v32, v32
  v_exp_f32 v33, v33
  v_exp_f32 v34, v34
  v_exp_f32 v35, v35
  v_exp_f32 v36, v36
  v_exp_f32 v37, v37
  v_exp_f32 v38, v38
  v_exp_f32 v39, v39
  v_pk_add_f32 v[32:33], v[32:33], 1.0 op_sel_hi:[1,0]
  v_pk_add_f32 v[34:35], v[34:35], 1.0 op_sel_hi:[1,0]
  v_pk_add_f32 v[36:37], v[36:37], 1.0 op_sel_hi:[1,0]
  v_pk_add_f32 v[38:39], v[38:39], 1.0 op_sel_hi:[1,0]
  v_rcp_f32 v32, v32
  v_rcp_f32 v33, v33
  v_rcp_f32 v34, v34
  v_rcp_f32 v35, v35
  v_rcp_f32 v36, v36
  v_rcp_f32 v37, v37
  v_rcp_f32 v38, v38
  v_rcp_f32 v39, v39
  v_pk_mul_f32 v[32:33], v[32:33], v[16:17]
  v_pk_mul_f32 v[34:35], v[34:35], v[18:19]
  v_pk_mul_f32 v[36:37], v[36:37], v[20:21]
  v_pk_mul_f32 v[38:39], v[38:39], v[22:23]
  v_cvt_pk_bf16_f32 v32, 0, v32
  v_cvt_pk_bf16_f32 v33, 0, v33
  v_cvt_pk_bf16_f32 v34, 0, v34
  v_cvt_pk_bf16_f32 v35, 0, v35
  v_cvt_pk_bf16_f32 v36, 0, v36
  v_cvt_pk_bf16_f32 v37, 0, v37
  v_cvt_pk_bf16_f32 v38, 0, v38
  v_cvt_pk_bf16_f32 v39, 0, v39
  v_pk_mul_f32 v[32:33], v[32:33], v[24:25]
  v_pk_mul_f32 v[34:35], v[34:35], v[26:27]
  v_pk_mul_f32 v[36:37], v[36:37], v[28:29]
  v_pk_mul_f32 v[38:39], v[38:39], v[30:31]
  v_cvt_pk_bf16_f32 v80, v32, v33
  v_cvt_pk_bf16_f32 v81, v34, v35
  v_cvt_pk_bf16_f32 v82, v36, v37
  v_cvt_pk_bf16_f32 v83, v38, v39
  v_min_u32 v80, -2, v80
  v_min_u32 v81, -2, v81
  v_min_u32 v82, -2, v82
  v_min_u32 v83, -2, v83
  buffer_store_dword v166, v165, s[32:35], 0 offen sc1
  v_cvt_pk_bf16_f32 v40, 0, v128
  v_cvt_pk_bf16_f32 v41, 0, v129
  v_cvt_pk_bf16_f32 v42, 0, v130
  v_cvt_pk_bf16_f32 v43, 0, v131
  v_cvt_pk_bf16_f32 v44, 0, v132
  v_cvt_pk_bf16_f32 v45, 0, v133
  v_cvt_pk_bf16_f32 v46, 0, v134
  v_cvt_pk_bf16_f32 v47, 0, v135
  v_cvt_pk_bf16_f32 v48, 0, v136
  v_cvt_pk_bf16_f32 v49, 0, v137
  v_cvt_pk_bf16_f32 v50, 0, v138
  v_cvt_pk_bf16_f32 v51, 0, v139
  v_cvt_pk_bf16_f32 v52, 0, v140
  v_cvt_pk_bf16_f32 v53, 0, v141
  v_cvt_pk_bf16_f32 v54, 0, v142
  v_cvt_pk_bf16_f32 v55, 0, v143
  v_pk_mul_f32 v[56:57], v[40:41], v[40:41]
  v_pk_mul_f32 v[58:59], v[42:43], v[42:43]
  v_pk_mul_f32 v[60:61], v[44:45], v[44:45]
  v_pk_mul_f32 v[62:63], v[46:47], v[46:47]
  v_pk_fma_f32 v[56:57], v[56:57], s[50:51], v[100:101]
  v_pk_fma_f32 v[58:59], v[58:59], s[50:51], v[100:101]
  v_pk_fma_f32 v[60:61], v[60:61], s[50:51], v[100:101]
  v_pk_fma_f32 v[62:63], v[62:63], s[50:51], v[100:101]
  v_pk_mul_f32 v[56:57], v[56:57], v[40:41]
  v_pk_mul_f32 v[58:59], v[58:59], v[42:43]
  v_pk_mul_f32 v[60:61], v[60:61], v[44:45]
  v_pk_mul_f32 v[62:63], v[62:63], v[46:47]
  v_exp_f32 v56, v56
  v_exp_f32 v57, v57
  v_exp_f32 v58, v58
  v_exp_f32 v59, v59
  v_exp_f32 v60, v60
  v_exp_f32 v61, v61
  v_exp_f32 v62, v62
  v_exp_f32 v63, v63
  v_pk_add_f32 v[56:57], v[56:57], 1.0 op_sel_hi:[1,0]
  v_pk_add_f32 v[58:59], v[58:59], 1.0 op_sel_hi:[1,0]
  v_pk_add_f32 v[60:61], v[60:61], 1.0 op_sel_hi:[1,0]
  v_pk_add_f32 v[62:63], v[62:63], 1.0 op_sel_hi:[1,0]
  v_rcp_f32 v56, v56
  v_rcp_f32 v57, v57
  v_rcp_f32 v58, v58
  v_rcp_f32 v59, v59
  v_rcp_f32 v60, v60
  v_rcp_f32 v61, v61
  v_rcp_f32 v62, v62
  v_rcp_f32 v63, v63
  v_pk_mul_f32 v[56:57], v[56:57], v[40:41]
  v_pk_mul_f32 v[58:59], v[58:59], v[42:43]
  v_pk_mul_f32 v[60:61], v[60:61], v[44:45]
  v_pk_mul_f32 v[62:63], v[62:63], v[46:47]
  v_cvt_pk_bf16_f32 v56, 0, v56
  v_cvt_pk_bf16_f32 v57, 0, v57
  v_cvt_pk_bf16_f32 v58, 0, v58
  v_cvt_pk_bf16_f32 v59, 0, v59
  v_cvt_pk_bf16_f32 v60, 0, v60
  v_cvt_pk_bf16_f32 v61, 0, v61
  v_cvt_pk_bf16_f32 v62, 0, v62
  v_cvt_pk_bf16_f32 v63, 0, v63
  v_pk_mul_f32 v[56:57], v[56:57], v[48:49]
  v_pk_mul_f32 v[58:59], v[58:59], v[50:51]
  v_pk_mul_f32 v[60:61], v[60:61], v[52:53]
  v_pk_mul_f32 v[62:63], v[62:63], v[54:55]
  v_cvt_pk_bf16_f32 v84, v56, v57
  v_cvt_pk_bf16_f32 v85, v58, v59
  v_cvt_pk_bf16_f32 v86, v60, v61
  v_cvt_pk_bf16_f32 v87, v62, v63
  v_min_u32 v84, -2, v84
  v_min_u32 v85, -2, v85
  v_min_u32 v86, -2, v86
  v_min_u32 v87, -2, v87
  s_barrier
  buffer_store_dwordx4 v[80:83], v5, s[32:35], s60 offen sc1
  buffer_store_dwordx4 v[84:87], v5, s[32:35], s61 offen sc1
  s_barrier
  s_branch L_p2g
L_bend:
.p2align 12
L_p2f:
  s_barrier
L_p2g:
  s_mov_b32 s24, 0xffffff00
  v_and_b32 v12, 1, v2
  v_mov_b32 v13, v148
  v_mov_b32 v14, v149
  v_mov_b32 v15, v150
  buffer_load_dword v4, v166, s[40:43], 0 offen sc1
  s_mov_b32 s59, 0
L_ha:
  s_load_dwordx4 s[92:95], s[20:21], 0 glc
  s_add_u32 s59, s59, 1
  s_cmp_ge_u32 s59, 65536
  s_waitcnt lgkmcnt(0)
  s_cbranch_scc1 L_hoka
  s_max_u32 s92, s92, s93
  s_max_u32 s92, s92, s94
  s_max_u32 s92, s92, s95
  s_cmp_eq_u32 s92, -1
  s_cbranch_scc1 L_ha
L_hoka:
  s_mov_b32 s59, 0
  s_barrier
L_sweep:
  buffer_load_dwordx4 v[16:19], v5, s[32:35], s54 offen offset:0 sc1
  buffer_load_dwordx4 v[20:23], v5, s[32:35], s54 offen offset:1024 sc1
  buffer_load_dwordx4 v[24:27], v5, s[32:35], s54 offen offset:2048 sc1
  buffer_load_dwordx4 v[28:31], v5, s[32:35], s54 offen offset:3072 sc1
  buffer_load_dwordx4 v[32:35], v5, s[32:35], s55 offen offset:0 sc1
  buffer_load_dwordx4 v[36:39], v5, s[32:35], s55 offen offset:1024 sc1
  s_cmp_lg_u32 s59, 0
  s_cbranch_scc1 L_nobw
  s_barrier
L_nobw:
  ds_read_b64_tr_b16 v[104:105], v160 offset:0
  ds_read_b64_tr_b16 v[106:107], v160 offset:1024
  ds_read_b64_tr_b16 v[108:109], v161 offset:0
  ds_read_b64_tr_b16 v[110:111], v161 offset:1024
  ds_read_b64_tr_b16 v[112:113], v160 offset:2048
  ds_read_b64_tr_b16 v[114:115], v160 offset:3072
  ds_read_b64_tr_b16 v[116:117], v161 offset:2048
  ds_read_b64_tr_b16 v[118:119], v161 offset:3072
  ds_read_b64_tr_b16 v[120:121], v160 offset:4096
  ds_read_b64_tr_b16 v[122:123], v160 offset:5120
  ds_read_b64_tr_b16 v[124:125], v161 offset:4096
  ds_read_b64_tr_b16 v[126:127], v161 offset:5120
  ds_read_b64_tr_b16 v[128:129], v160 offset:6144
  ds_read_b64_tr_b16 v[130:131], v160 offset:7168
  ds_read_b64_tr_b16 v[132:133], v161 offset:6144
  ds_read_b64_tr_b16 v[134:135], v161 offset:7168
  ds_read_b64_tr_b16 v[136:137], v160 offset:8192
  ds_read_b64_tr_b16 v[138:139], v160 offset:9216
  ds_read_b64_tr_b16 v[140:141], v161 offset:8192
  ds_read_b64_tr_b16 v[142:143], v161 offset:9216
  ds_read_b64_tr_b16 v[144:145], v160 offset:10240
  ds_read_b64_tr_b16 v[146:147], v160 offset:11264
  ds_read_b64_tr_b16 v[148:149], v161 offset:10240
  ds_read_b64_tr_b16 v[150:151], v161 offset:11264
  ds_read_b64_tr_b16 v[152:153], v160 offset:12288
  ds_read_b64_tr_b16 v[154:155], v160 offset:13312
  ds_read_b64_tr_b16 v[156:157], v161 offset:12288
  ds_read_b64_tr_b16 v[158:159], v161 offset:13312
  v_mov_b32 v164, 0
  s_waitcnt vmcnt(5) lgkmcnt(15)
  v_mfma_f32_32x32x16_bf16 v[88:103], v[108:111], v[16:19], 0
  buffer_load_dwordx4 v[40:43], v5, s[32:35], s55 offen offset:2048 sc1
  v_max3_u32 v164, v16, v17, v164
  v_max3_u32 v164, v18, v19, v164
  v_mfma_f32_32x32x16_bf16 v[72:87], v[104:107], v[16:19], 0
  ds_read_b64_tr_b16 v[104:105], v160 offset:14336
  ds_read_b64_tr_b16 v[106:107], v160 offset:15360
  ds_read_b64_tr_b16 v[108:109], v161 offset:14336
  ds_read_b64_tr_b16 v[110:111], v161 offset:15360
  s_waitcnt vmcnt(5) lgkmcnt(15)
  v_mfma_f32_32x32x16_bf16 v[88:103], v[116:119], v[20:23], v[88:103]
  buffer_load_dwordx4 v[44:47], v5, s[32:35], s55 offen offset:3072 sc1
  v_max3_u32 v164, v20, v21, v164
  v_max3_u32 v164, v22, v23, v164
  v_mfma_f32_32x32x16_bf16 v[72:87], v[112:115], v[20:23], v[72:87]
  ds_read_b64_tr_b16 v[112:113], v160 offset:16384
  ds_read_b64_tr_b16 v[114:115], v160 offset:17408
  ds_read_b64_tr_b16 v[116:117], v161 offset:16384
  ds_read_b64_tr_b16 v[118:119], v161 offset:17408
  s_waitcnt vmcnt(5) lgkmcnt(15)
  v_mfma_f32_32x32x16_bf16 v[88:103], v[124:127], v[24:27], v[88:103]
  buffer_load_dwordx4 v[48:51], v5, s[32:35], s56 offen offset:0 sc1
  v_max3_u32 v164, v24, v25, v164
  v_max3_u32 v164, v26, v27, v164
  v_mfma_f32_32x32x16_bf16 v[72:87], v[120:123], v[24:27], v[72:87]
  ds_read_b64_tr_b16 v[120:121], v160 offset:18432
  ds_read_b64_tr_b16 v[122:123], v160 offset:19456
  ds_read_b64_tr_b16 v[124:125], v161 offset:18432
  ds_read_b64_tr_b16 v[126:127], v161 offset:19456
  s_waitcnt vmcnt(5) lgkmcnt(15)
  v_mfma_f32_32x32x16_bf16 v[88:103], v[132:135], v[28:31], v[88:103]
  buffer_load_dwordx4 v[52:55], v5, s[32:35], s56 offen offset:1024 sc1
  v_max3_u32 v164, v28, v29, v164
  v_max3_u32 v164, v30, v31, v164
  v_mfma_f32_32x32x16_bf16 v[72:87], v[128:131], v[28:31], v[72:87]
  ds_read_b64_tr_b16 v[128:129], v160 offset:20480
  ds_read_b64_tr_b16 v[130:131], v160 offset:21504
  ds_read_b64_tr_b16 v[132:133], v161 offset:20480
  ds_read_b64_tr_b16 v[134:135], v161 offset:21504
  s_waitcnt vmcnt(5) lgkmcnt(15)
  v_mfma_f32_32x32x16_bf16 v[88:103], v[140:143], v[32:35], v[88:103]
  buffer_load_dwordx4 v[56:59], v5, s[32:35], s56 offen offset:2048 sc1
  v_max3_u32 v164, v32, v33, v164
  v_max3_u32 v164, v34, v35, v164
  v_mfma_f32_32x32x16_bf16 v[72:87], v[136:139], v[32:35], v[72:87]
  ds_read_b64_tr_b16 v[136:137], v160 offset:22528
  ds_read_b64_tr_b16 v[138:139], v160 offset:23552
  ds_read_b64_tr_b16 v[140:141], v161 offset:22528
  ds_read_b64_tr_b16 v[142:143], v161 offset:23552
  s_waitcnt vmcnt(5) lgkmcnt(15)
  v_mfma_f32_32x32x16_bf16 v[88:103], v[148:151], v[36:39], v[88:103]
  buffer_load_dwordx4 v[60:63], v5, s[32:35], s56 offen offset:3072 sc1
  v_max3_u32 v164, v36, v37, v164
  v_max3_u32 v164, v38, v39, v164
  v_mfma_f32_32x32x16_bf16 v[72:87], v[144:147], v[36:39], v[72:87]
  ds_read_b64_tr_b16 v[144:145], v160 offset:24576
  ds_read_b64_tr_b16 v[146:147], v160 offset:25600
  ds_read_b64_tr_b16 v[148:149], v161 offset:24576
  ds_read_b64_tr_b16 v[150:151], v161 offset:25600
  s_waitcnt vmcnt(5) lgkmcnt(15)
  v_mfma_f32_32x32x16_bf16 v[88:103], v[156:159], v[40:43], v[88:103]
  buffer_load_dwordx4 v[64:67], v5, s[32:35], s57 offen offset:0 sc1
  v_max3_u32 v164, v40, v41, v164
  v_max3_u32 v164, v42, v43, v164
  v_mfma_f32_32x32x16_bf16 v[72:87], v[152:155], v[40:43], v[72:87]
  ds_read_b64_tr_b16 v[152:153], v160 offset:26624
  ds_read_b64_tr_b16 v[154:155], v160 offset:27648
  ds_read_b64_tr_b16 v[156:157], v161 offset:26624
  ds_read_b64_tr_b16 v[158:159], v161 offset:27648
  s_waitcnt vmcnt(5) lgkmcnt(15)
  v_mfma_f32_32x32x16_bf16 v[88:103], v[108:111], v[44:47], v[88:103]
  buffer_load_dwordx4 v[68:71], v5, s[32:35], s57 offen offset:1024 sc1
  v_max3_u32 v164, v44, v45, v164
  v_max3_u32 v164, v46, v47, v164
  v_mfma_f32_32x32x16_bf16 v[72:87], v[104:107], v[44:47], v[72:87]
  s_waitcnt vmcnt(5) lgkmcnt(15)
  v_mfma_f32_32x32x16_bf16 v[88:103], v[116:119], v[48:51], v[88:103]
  v_max3_u32 v164, v48, v49, v164
  v_max3_u32 v164, v50, v51, v164
  v_mfma_f32_32x32x16_bf16 v[72:87], v[112:115], v[48:51], v[72:87]
  v_and_b32 v6, 0xff, v4
  v_bfe_u32 v7, v4, 8, 8
  v_bfe_u32 v8, v4, 16, 8
  v_cmp_eq_u32 vcc, 1, v12
  s_waitcnt vmcnt(4) lgkmcnt(15)
  v_mfma_f32_32x32x16_bf16 v[88:103], v[124:127], v[52:55], v[88:103]
  v_max3_u32 v164, v52, v53, v164
  v_max3_u32 v164, v54, v55, v164
  v_mfma_f32_32x32x16_bf16 v[72:87], v[120:123], v[52:55], v[72:87]
  v_lshrrev_b32 v9, 24, v4
  v_cndmask_b32 v10, v6, v8, vcc
  v_cndmask_b32 v11, v7, v9, vcc
  s_waitcnt vmcnt(3) lgkmcnt(12)
  v_mfma_f32_32x32x16_bf16 v[88:103], v[132:135], v[56:59], v[88:103]
  v_max3_u32 v164, v56, v57, v164
  v_max3_u32 v164, v58, v59, v164
  v_mfma_f32_32x32x16_bf16 v[72:87], v[128:131], v[56:59], v[72:87]
  s_waitcnt vmcnt(2) lgkmcnt(8)
  v_mfma_f32_32x32x16_bf16 v[88:103], v[140:143], v[60:63], v[88:103]
  v_max3_u32 v164, v60, v61, v164
  v_max3_u32 v164, v62, v63, v164
  v_mfma_f32_32x32x16_bf16 v[72:87], v[136:139], v[60:63], v[72:87]
  s_waitcnt vmcnt(1) lgkmcnt(4)
  v_mfma_f32_32x32x16_bf16 v[88:103], v[148:151], v[64:67], v[88:103]
  v_max3_u32 v164, v64, v65, v164
  v_max3_u32 v164, v66, v67, v164
  v_mfma_f32_32x32x16_bf16 v[72:87], v[144:147], v[64:67], v[72:87]
  s_waitcnt vmcnt(0) lgkmcnt(0)
  v_mfma_f32_32x32x16_bf16 v[88:103], v[156:159], v[68:71], v[88:103]
  v_max3_u32 v164, v68, v69, v164
  v_max3_u32 v164, v70, v71, v164
  v_mfma_f32_32x32x16_bf16 v[72:87], v[152:155], v[68:71], v[72:87]
  v_cmp_eq_u32 vcc, -1, v164
  s_add_u32 s59, s59, 1
  s_cbranch_vccz L_swok
  s_cmp_lt_u32 s59, 65536
  s_cbranch_scc1 L_sweep
L_swok:
  v_xor_b32 v16, 0x4000, v3
  v_xor_b32 v17, 0x6000, v3
  v_xor_b32 v18, 0x2000, v3
  s_nop 3
  ds_write_b128 v16, v[88:91] offset:4096
  ds_write_b128 v16, v[92:95] offset:5120
  ds_write_b128 v17, v[96:99] offset:6144
  ds_write_b128 v17, v[100:103] offset:7168
  ds_write_b128 v18, v[80:83] offset:2048
  ds_write_b128 v18, v[84:87] offset:3072
  s_waitcnt lgkmcnt(0)
  s_barrier
  ds_read_b128 v[16:19], v3 offset:2048
  ds_read_b128 v[20:23], v3 offset:4096
  ds_read_b128 v[24:27], v3 offset:6144
  ds_read_b128 v[28:31], v3 offset:3072
  ds_read_b128 v[32:35], v3 offset:5120
  ds_read_b128 v[36:39], v3 offset:7168
  buffer_store_dword v166, v167, s[32:35], 0 offen sc1
  s_waitcnt lgkmcnt(4)
  v_pk_add_f32 v[16:17], v[16:17], v[72:73]
  v_pk_add_f32 v[18:19], v[18:19], v[74:75]
  s_waitcnt lgkmcnt(3)
  v_pk_add_f32 v[20:21], v[20:21], v[24:25]
  v_pk_add_f32 v[22:23], v[22:23], v[26:27]
  v_pk_add_f32 v[16:17], v[16:17], v[20:21]
  v_pk_add_f32 v[18:19], v[18:19], v[22:23]
  v_and_or_b32 v20, v16, s24, v6
  v_and_or_b32 v21, v17, s24, v7
  v_and_or_b32 v22, v18, s24, v8
  v_and_or_b32 v23, v19, s24, v9
  buffer_store_dwordx4 v[20:23], v13, s[32:35], s52 offen offset:0 sc1
  s_waitcnt lgkmcnt(1)
  v_pk_add_f32 v[28:29], v[28:29], v[76:77]
  v_pk_add_f32 v[30:31], v[30:31], v[78:79]
  s_waitcnt lgkmcnt(0)
  v_pk_add_f32 v[32:33], v[32:33], v[36:37]
  v_pk_add_f32 v[34:35], v[34:35], v[38:39]
  v_pk_add_f32 v[28:29], v[28:29], v[32:33]
  v_pk_add_f32 v[30:31], v[30:31], v[34:35]
  v_and_or_b32 v32, v28, s24, v6
  v_and_or_b32 v33, v29, s24, v7
  v_and_or_b32 v34, v30, s24, v8
  v_and_or_b32 v35, v31, s24, v9
  buffer_store_dwordx4 v[32:35], v13, s[32:35], s52 offen offset:256 sc1
  s_mov_b64 exec, s[28:29]
  ds_write_b128 v14, v[16:19] offset:32768
  ds_write_b128 v14, v[28:31] offset:33024
  s_mov_b64 exec, -1
  ds_read_b64 v[46:47], v163 offset:32768
  s_mov_b32 s59, 0
  s_barrier
L_gat:
  buffer_load_dwordx2 v[40:41], v163, s[32:35], s16 offen sc1
  buffer_load_dwordx2 v[42:43], v163, s[32:35], s17 offen sc1
  buffer_load_dwordx2 v[44:45], v163, s[32:35], s18 offen sc1
  s_add_u32 s59, s59, 1
  s_cmp_ge_u32 s59, 65536
  s_waitcnt vmcnt(0)
  v_xor_b32 v40, v40, v10
  v_xor_b32 v41, v41, v11
  v_xor_b32 v42, v42, v10
  v_xor_b32 v43, v43, v11
  v_xor_b32 v44, v44, v10
  v_xor_b32 v45, v45, v11
  v_or3_b32 v164, v40, v41, v42
  v_or3_b32 v164, v164, v43, v44
  v_or_b32 v164, v164, v45
  v_and_b32 v164, 0xff, v164
  v_cmp_ne_u32 vcc, 0, v164
  s_waitcnt lgkmcnt(0)
  v_pk_add_f32 v[40:41], v[40:41], v[42:43]
  v_pk_add_f32 v[44:45], v[44:45], v[46:47]
  s_cbranch_scc1 L_gok
  s_cbranch_vccnz L_gat
L_gok:
  v_pk_add_f32 v[40:41], v[40:41], v[44:45]
  v_cvt_pk_bf16_f32 v40, v40, v41
  ds_write_b32 v162, v40 offset:36864
  s_cmp_lg_u32 s62, 0
  s_waitcnt lgkmcnt(0)
  s_barrier
  s_cbranch_scc1 L_fin
  ds_read_b128 v[40:43], v5 offset:36864
  s_waitcnt lgkmcnt(0)
  buffer_store_dwordx4 v[40:43], v15, s[36:39], s58 offen sc1
L_fin:
  s_endpgm
L_fslow:
  s_mov_b32 s59, 0
L_fa:
  v_cmp_ne_u32 vcc, v144, v145
  v_cmp_eq_u32 s[26:27], 0, v145
  s_or_b64 vcc, vcc, s[26:27]
  s_cbranch_vccz L_foka
  s_add_u32 s59, s59, 1
  s_cmp_ge_u32 s59, 65536
  s_cbranch_scc1 L_foka
  s_sleep 8
  buffer_load_dword v145, v166, s[40:43], 0 offen sc1
  buffer_load_dword v144, v146, s[32:35], 0 offen sc1
  s_waitcnt vmcnt(0)
  s_branch L_fa
L_foka:
  s_branch L_flb2
.section .rodata,"a"
.p2align 6
.amdhsa_kernel standalone__glu_gated_geglu__sampling_kernel
  .amdhsa_next_free_vgpr 168
  .amdhsa_next_free_sgpr 102
  .amdhsa_accum_offset 168
  .amdhsa_group_segment_fixed_size 0
  .amdhsa_kernarg_size 56
  .amdhsa_user_sgpr_count 2
  .amdhsa_user_sgpr_kernarg_segment_ptr 1
  .amdhsa_system_sgpr_workgroup_id_x 1
  .amdhsa_float_denorm_mode_32 3
.end_amdhsa_kernel
```
